```python
import torch

def _softmax(x, axis=-1):
    return torch.softmax(x, dim=axis)
def _gelu(x):
    return torch.nn.functional.gelu(x, approximate="tanh")
def _silu(x):
    return torch.nn.functional.silu(x)
def _sigmoid(x):
    return torch.sigmoid(x)
def _layernorm(x, axis=-1, eps=1e-5):
    m = x.mean(dim=axis, keepdim=True)
    v = x.var(dim=axis, keepdim=True, unbiased=False)
    return (x - m) / torch.sqrt(v + eps)
def _scatter_add(tgt, idx, src, axis=0):
    return tgt.clone().index_add_(axis, idx, src)
def _segment_sum(src, seg, n):
    out = torch.zeros((n,) + src.shape[1:], dtype=src.dtype)
    return out.index_add_(0, seg, src)
def _pad(x, pw):
    flat = tuple(v for pair in reversed(pw) for v in pair)
    return torch.nn.functional.pad(x, flat)

kernel_name = 'gated_mix__sliding_block_cached__dense_activation_squared_relu__decode'

def setup_inputs():

    _w = (lambda a: (lambda t: t.to(torch.bfloat16) if t.is_floating_point() else t)(torch.as_tensor(a)))
    def _A_setup():
        B, Sq, D = 1, 1, 448
        Hq, Hkv, Sk, Dh = 16, 8, 65536, 256
        assert Hq % Hkv == 0, (Hq, Hkv)
        return {
            "x": _w((lambda *s: torch.randn(*s, dtype=torch.bfloat16) * 0.05)(B, Sq, D)),
            "k_cache": _w((lambda *s: torch.randn(*s, dtype=torch.bfloat16) * 3.2)(B, Hkv, Sk, Dh)),
            "v_cache": _w((lambda *s: torch.randn(*s, dtype=torch.bfloat16) * 1.6)(B, Hkv, Sk, Dh)),
            "wq": _w((lambda *s: torch.randn(*s, dtype=torch.bfloat16) * 3.2)(D, Hq * Dh) * (D ** -0.5)),
            "wo": _w((lambda *s: torch.randn(*s, dtype=torch.bfloat16) * 1.6)(Hq * Dh, D) * ((Hq * Dh) ** -0.5)),
        }
    _A_in = _A_setup()

    def _B_setup():
        B, S, D, F = 1, 1, 448, 1792
        return {
            "x": _w((lambda *s: torch.randn(*s, dtype=torch.bfloat16) * 0.05)(B, S, D)),
            "w1": _w((lambda *s: torch.randn(*s, dtype=torch.bfloat16) * 0.1)(D, F)),
            "b1": _w((lambda *s: torch.randn(*s, dtype=torch.bfloat16) * 0.05)(F)),
            "w2": _w((lambda *s: torch.randn(*s, dtype=torch.bfloat16) * 0.05)(F, D)),
            "b2": _w((lambda *s: torch.randn(*s, dtype=torch.bfloat16) * 0.05)(D)),
        }
    _B_in = _B_setup()

    return {
        "A_x": _A_in["x"],
        "A_k_cache": _A_in["k_cache"],
        "A_v_cache": _A_in["v_cache"],
        "A_wq": _A_in["wq"],
        "A_wo": _A_in["wo"],
        "B_x": _B_in["x"],
        "B_w1": _B_in["w1"],
        "B_b1": _B_in["b1"],
        "B_w2": _B_in["w2"],
        "B_b2": _B_in["b2"],
        "gate_w": _w((lambda *s: torch.randn(*s, dtype=torch.bfloat16) * 0.05)(448) * 16.0),
    }

def reference(A_x, A_k_cache, A_v_cache, A_wq, A_wo, B_x, B_w1, B_b1, B_w2, B_b2, gate_w):
    def _A_ref(x, k_cache, v_cache, wq, wo):
        B, Sq, D = x.shape
        Hq, Dh = 16, 256
        Hkv, Sk = k_cache.shape[1], k_cache.shape[2]
        W = min(4096, max(256, Sk // 4))
        rep = Hq // Hkv
        q = (lambda x, *d: x.permute(*d))((x @ wq).reshape(B, Sq, Hq, Dh), 0, 2, 1, 3)
        k = (lambda x, n, axis: torch.repeat_interleave(x, n, dim=axis))(k_cache[:, :, Sk - W:, :], rep, axis=1)
        v = (lambda x, n, axis: torch.repeat_interleave(x, n, dim=axis))(v_cache[:, :, Sk - W:, :], rep, axis=1)
        scores = torch.einsum("bhqd,bhkd->bhqk", q, k) * (Dh ** -0.5)
        p = _softmax(scores, axis=-1)
        o = torch.einsum("bhqk,bhkd->bhqd", p, v)
        return (lambda x, *d: x.permute(*d))(o, 0, 2, 1, 3).reshape(B, Sq, Hq * Dh) @ wo

    def _B_ref(x, w1, b1, w2, b2):
        h = torch.einsum("bsd,df->bsf", x, w1) + b1
        zero = torch.zeros_like(h)
        r = torch.where(h > zero, h, zero)
        h = r * r
        out = torch.einsum("bsf,fd->bsd", h, w2) + b2
        return out

    x = A_x
    g = _sigmoid((x * gate_w).sum(-1, keepdims=True))
    a = _A_ref(x, A_k_cache, A_v_cache, A_wq, A_wo)
    b = _B_ref(x, B_w1, B_b1, B_w2, B_b2)
    return g * a + (1 - g) * b
```

```asm
; @launch grid=(256,1,1) block=(1024,1,1) lds=158720
.amdgcn_target "amdgcn-amd-amdhsa--gfx950"
.text
.globl gated_mix__sliding_block_cached__dense_activation_squared_relu__decode_kernel
.p2align 8
.type gated_mix__sliding_block_cached__dense_activation_squared_relu__decode_kernel,@function
gated_mix__sliding_block_cached__dense_activation_squared_relu__decode_kernel:
    s_cmp_ge_u32 s2, 256
    s_cbranch_scc1 L_end
    s_load_dwordx16 s[16:31], s[0:1], 0
    s_load_dwordx8 s[32:39], s[0:1], 64
    s_load_dwordx4 s[40:43], s[0:1], 96
    v_lshrrev_b32 v1, 6, v0
    v_and_b32 v0, 63, v0
    s_and_b32 s4, s2, 7
    s_lshr_b32 s5, s2, 3
    v_readfirstlane_b32 s3, v1
    s_add_u32 s93, s5, 4
    s_lshr_b32 s93, s93, 3
    s_sub_u32 s93, s5, s93
    s_lshr_b32 s94, s5, 3
    s_add_u32 s94, s94, 28
    s_and_b32 s95, s5, 7
    s_cmp_eq_u32 s95, 3
    s_cselect_b32 s93, s94, s93
    s_lshr_b32 s94, s93, 2
    s_and_b32 s95, s93, 3
    s_cmp_lt_u32 s93, 28
    s_cselect_b32 s96, 1, 0
    s_cmp_lt_u32 s4, 7
    s_cselect_b32 s97, 1, 0
    s_mov_b32 s99, s96
    s_and_b32 s96, s96, s97
    s_mul_i32 s100, s93, 37
    s_lshr_b32 s100, s100, 8
    s_mul_i32 s101, s100, 7
    s_sub_u32 s101, s93, s101
    s_cmp_ge_u32 s3, 8
    s_cbranch_scc1 L_aux
    s_lshl_b32 s10, s3, 10
    v_lshrrev_b32 v8, 3, v0
    v_and_b32 v9, 7, v0
    v_lshlrev_b32 v9, 4, v9
    v_lshl_add_u32 v10, v8, 13, v9
    v_mul_u32_u24 v11, 3584, v8
    v_add_u32 v11, v11, v9
    v_lshlrev_b32 v12, 4, v0
    s_lshr_b32 s11, s5, 3
    s_mul_i32 s11, s11, 917504
    s_and_b32 s12, s5, 7
    s_lshl_b32 s12, s12, 7
    s_add_u32 s11, s11, s12
    s_lshl_b32 s12, s4, 10
    s_add_u32 s11, s11, s12
    s_lshl_b32 s12, s3, 16
    s_add_u32 s11, s11, s12
    s_mul_i32 s12, s94, 229376
    s_lshl_b32 s13, s95, 7
    s_add_u32 s12, s12, s13
    s_lshl_b32 s13, s4, 9
    s_add_u32 s12, s12, s13
    s_mul_i32 s13, s3, 28672
    s_add_u32 s12, s12, s13
    s_mul_i32 s13, s96, 1605632
    s_add_u32 m0, s10, 133632
    s_waitcnt lgkmcnt(0)
    s_mov_b32 s56, s22
    s_mov_b32 s57, s23
    s_mov_b32 s58, 3670016
    s_mov_b32 s59, 0x20000
    buffer_load_dwordx4 v10, s[56:59], s11 offen nt lds
    s_mov_b32 s60, s28
    s_mov_b32 s61, s29
    s_mov_b32 s62, s13
    s_mov_b32 s63, 0x20000
    s_cmp_ge_u32 s3, 6
    s_cbranch_scc1 L_spre67
    s_add_u32 m0, s10, 141824
    s_add_u32 s11, s11, 524288
    buffer_load_dwordx4 v10, s[56:59], s11 offen nt lds
    s_add_u32 m0, s10, 150016
    s_add_u32 s12, s12, 57344
    buffer_load_dwordx4 v11, s[60:63], s12 offen nt lds
    s_branch L_spre_done
L_spre67:
    s_add_u32 m0, s10, 141824
    s_sub_u32 s12, s12, 172032
    buffer_load_dwordx4 v11, s[60:63], s12 offen nt lds
    s_cmp_eq_u32 s3, 6
    s_cselect_b32 s56, s16, s36
    s_cselect_b32 s57, s17, s37
    s_mov_b32 s58, 896
    s_add_u32 m0, s10, 150016
    s_nop 0
    buffer_load_dwordx4 v12, s[56:59], 0 offen lds
L_spre_done:
    s_lshl_b32 s12, s4, 5
    s_add_u32 s12, s12, s5
    s_lshl_b32 s11, s12, 11
    s_add_u32 s11, s11, s10
    s_add_u32 s11, s11, 1046528
    s_mov_b32 s14, 1023
    s_lshl_b32 s12, s12, 8
    s_add_u32 s13, s12, 65536
    s_cmp_eq_u32 s3, 1
    s_cselect_b32 s11, s13, s11
    s_cselect_b32 s14, 255, s14
    s_add_u32 s13, s12, 131072
    s_cmp_eq_u32 s3, 4
    s_cselect_b32 s11, s13, s11
    s_cselect_b32 s14, 255, s14
    s_lshl_b32 s13, s4, 9
    s_add_u32 s13, s13, 327680
    s_cmp_eq_u32 s3, 5
    s_cselect_b32 s11, s13, s11
    s_cselect_b32 s14, 511, s14
    s_sub_u32 s13, s3, 1
    s_cmp_ge_u32 s13, 5
    s_cselect_b32 s11, 0, s11
    s_cselect_b32 s14, 0, s14
    v_and_b32 v77, s14, v12
    v_add_u32 v77, s11, v77
    s_cmp_eq_u32 s14, 0
    s_cbranch_scc1 L_ep_plain
    global_load_dword v78, v77, s[42:43] sc1 nt
    s_branch L_ep_done
L_ep_plain:
    global_load_dword v78, v77, s[42:43] sc1
L_ep_done:
    v_lshrrev_b32 v2, 5, v0
    v_and_b32 v3, 31, v0
    v_xor_b32 v4, v3, v2
    v_lshlrev_b32 v4, 4, v4
    v_lshl_add_u32 v4, v2, 9, v4
    s_lshl_b32 s6, s3, 13
    v_add_u32 v4, s6, v4
    s_lshl_b32 s7, s3, 1
    v_add_u32 v5, s7, v2
    v_and_b32 v6, 7, v5
    v_lshlrev_b32 v6, 1, v6
    v_xor_b32 v6, v3, v6
    v_lshlrev_b32 v6, 4, v6
    v_lshl_add_u32 v6, v5, 9, v6
    s_lshl_b32 s8, s4, 25
    s_lshl_b32 s9, s5, 16
    s_add_u32 s8, s8, s9
    s_add_u32 s8, s8, 31457280
    s_mov_b32 s48, s18
    s_mov_b32 s49, s19
    s_mov_b32 s50, 268435456
    s_mov_b32 s51, 0x20000
    s_mov_b32 s52, s20
    s_mov_b32 s53, s21
    s_mov_b32 s54, 268435456
    s_mov_b32 s55, 0x20000
    s_add_u32 s10, s10, 65536
    s_barrier
    s_add_u32 m0, s6, 0
    s_add_u32 s11, s8, 0
    v_xor_b32 v7, 0, v4
    buffer_load_dwordx4 v7, s[48:51], s11 offen nt lds
    s_add_u32 m0, s6, 1024
    s_add_u32 s11, s8, 1024
    v_xor_b32 v7, 32, v4
    buffer_load_dwordx4 v7, s[48:51], s11 offen nt lds
    s_add_u32 m0, s6, 2048
    s_add_u32 s11, s8, 2048
    v_xor_b32 v7, 64, v4
    buffer_load_dwordx4 v7, s[48:51], s11 offen nt lds
    s_lshl_b32 s12, s3, 2
    s_add_u32 s12, s12, 133152
    v_mov_b32 v106, s12
    v_mov_b32 v107, 1
    v_mov_b32 v95, 133136
    v_lshrrev_b32 v8, 3, v0
    v_mul_u32_u24 v11, 896, v8
    v_add_u32 v11, v11, v9
    s_lshl_b32 s80, s3, 10
    s_lshl_b32 s81, s4, 9
    s_bfe_u32 s12, s3, 0x10001
    s_lshl_b32 s12, s12, 8
    s_add_u32 s81, s81, s12
    s_lshl_b32 s12, s100, 6
    s_add_u32 s81, s81, s12
    s_and_b32 s12, s3, 1
    s_lshl_b32 s12, s12, 4
    s_add_u32 s81, s81, s12
    s_lshr_b32 s12, s3, 2
    s_lshl_b32 s12, s12, 3
    s_add_u32 s81, s81, s12
    s_mul_i32 s81, s81, 896
    s_lshl_b32 s13, s101, 7
    s_add_u32 s81, s81, s13
    s_lshl_b32 s82, s4, 8
    s_lshl_b32 s12, s100, 6
    s_add_u32 s82, s82, s12
    s_lshl_b32 s12, s3, 3
    s_add_u32 s82, s82, s12
    s_mul_i32 s82, s82, 896
    s_add_u32 s82, s82, s13
    s_mul_i32 s11, s99, 3670016
    s_mul_i32 s12, s96, 1605632
    s_mov_b32 s84, s24
    s_mov_b32 s85, s25
    s_mov_b32 s86, s11
    s_mov_b32 s87, 0x20000
    s_mov_b32 s88, s32
    s_mov_b32 s89, s33
    s_mov_b32 s90, s12
    s_mov_b32 s91, 0x20000
    s_lshl_b32 s11, s101, 2
    s_and_b32 s12, s3, 3
    s_add_u32 s11, s11, s12
    s_lshl_b32 s11, s11, 5
    s_lshl_b32 s12, s4, 2
    s_add_u32 s11, s11, s12
    s_and_b32 s12, s100, 3
    s_add_u32 s11, s11, s12
    s_lshl_b32 s11, s11, 7
    s_add_u32 s11, s11, 393216
    v_mov_b32 v94, s11
    v_mov_b32 v93, 133248
    s_mov_b32 s16, 0x7060500
    s_mov_b32 s17, 0x7060501
    s_mov_b32 s18, 0x7060502
    s_mov_b32 s19, 0x7060503
    s_mov_b32 s20, 0x0c0c0400
    s_mov_b32 s21, 0x04000c0c
    s_mov_b32 s22, 0xffffff00
    s_waitcnt vmcnt(3)
    s_cmp_eq_u32 s3, 0
    s_cbranch_scc0 L_noep
    ds_write_b32 v93, v78
    s_waitcnt lgkmcnt(0)
L_noep:
    ds_write_b32 v106, v107 offset:64
    s_waitcnt vmcnt(2)
    s_add_u32 m0, s6, 3072
    s_add_u32 s11, s8, 3072
    v_xor_b32 v7, 96, v4
    buffer_load_dwordx4 v7, s[48:51], s11 offen nt lds
    s_waitcnt vmcnt(2)
    s_add_u32 m0, s6, 4096
    s_add_u32 s11, s8, 4096
    v_xor_b32 v7, 128, v4
    buffer_load_dwordx4 v7, s[48:51], s11 offen nt lds
    s_waitcnt vmcnt(2)
    ds_write_b32 v106, v107 offset:288
    s_add_u32 m0, s6, 5120
    s_add_u32 s11, s8, 5120
    v_xor_b32 v7, 160, v4
    buffer_load_dwordx4 v7, s[48:51], s11 offen nt lds
    s_waitcnt vmcnt(2)
    s_add_u32 m0, s6, 6144
    s_add_u32 s11, s8, 6144
    v_xor_b32 v7, 192, v4
    buffer_load_dwordx4 v7, s[48:51], s11 offen nt lds
    s_waitcnt vmcnt(2)
    s_add_u32 m0, s6, 7168
    s_add_u32 s11, s8, 7168
    v_xor_b32 v7, 224, v4
    buffer_load_dwordx4 v7, s[48:51], s11 offen nt lds
    s_waitcnt vmcnt(2)
    s_add_u32 m0, s10, 0
    s_add_u32 s11, s8, 0
    buffer_load_dwordx4 v6, s[52:55], s11 offen nt lds
    s_waitcnt vmcnt(2)
    s_add_u32 m0, s10, 8192
    s_add_u32 s11, s8, 8192
    buffer_load_dwordx4 v6, s[52:55], s11 offen nt lds
    s_waitcnt vmcnt(2)
    ds_write_b32 v106, v107 offset:0
    s_add_u32 m0, s10, 16384
    s_add_u32 s11, s8, 16384
    buffer_load_dwordx4 v6, s[52:55], s11 offen nt lds
    s_waitcnt vmcnt(2)
    s_add_u32 m0, s10, 24576
    s_add_u32 s11, s8, 24576
    buffer_load_dwordx4 v6, s[52:55], s11 offen nt lds
    s_waitcnt vmcnt(2)
    s_add_u32 m0, s10, 32768
    s_add_u32 s11, s8, 32768
    buffer_load_dwordx4 v6, s[52:55], s11 offen nt lds
    s_waitcnt vmcnt(2)
    s_add_u32 m0, s10, 40960
    s_add_u32 s11, s8, 40960
    buffer_load_dwordx4 v6, s[52:55], s11 offen nt lds
    s_waitcnt vmcnt(2)
    s_add_u32 m0, s10, 49152
    s_add_u32 s11, s8, 49152
    buffer_load_dwordx4 v6, s[52:55], s11 offen nt lds
    s_waitcnt vmcnt(2)
    s_add_u32 m0, s10, 57344
    s_add_u32 s11, s8, 57344
    buffer_load_dwordx4 v6, s[52:55], s11 offen nt lds
    s_waitcnt vmcnt(2)
    ds_write_b32 v106, v107 offset:128
    s_mov_b32 s15, 0
L_sfwa:
    ds_read_b128 v[84:87], v95 offset:128
    ds_read_b128 v[88:91], v95 offset:272
    s_add_u32 s15, s15, 1
    s_cmp_gt_u32 s15, 16000000
    s_cbranch_scc1 L_sfwa_ok
    s_waitcnt lgkmcnt(0)
    v_and_b32 v84, v84, v85
    v_and_b32 v86, v86, v87
    v_and_b32 v88, v88, v89
    v_and_b32 v90, v90, v91
    v_and_b32 v84, v84, v86
    v_and_b32 v88, v88, v90
    v_and_b32 v84, v84, v88
    s_nop 0
    v_readfirstlane_b32 s12, v84
    s_bitcmp1_b32 s12, 0
    s_cbranch_scc0 L_sfwa
L_sfwa_ok:
    s_waitcnt lgkmcnt(0)
    s_add_u32 m0, s80, 133632
    s_add_u32 s11, s81, 0
    buffer_load_dwordx4 v11, s[84:87], s11 offen nt lds
    s_waitcnt vmcnt(2)
    s_add_u32 m0, s80, 141824
    s_add_u32 s11, s81, 28672
    buffer_load_dwordx4 v11, s[84:87], s11 offen nt lds
    s_waitcnt vmcnt(2)
    ds_write_b32 v106, v107 offset:160
    s_add_u32 m0, s80, 150016
    s_nop 0
    buffer_load_dwordx4 v11, s[88:91], s82 offen nt lds
    s_waitcnt vmcnt(2)
    global_load_dword v92, v94, s[42:43] sc1
    s_waitcnt vmcnt(1)
    ds_write_b32 v106, v107 offset:224
    s_endpgm
L_aux:
    s_cmp_eq_u32 s3, 12
    s_cbranch_scc0 L_noinit
    v_mov_b32 v8, 133136
    v_mov_b32 v10, 0
    v_mov_b32 v11, 0
    v_mov_b32 v12, 0
    v_mov_b32 v13, 0
    ds_write_b128 v8, v[10:13] offset:0
    ds_write_b128 v8, v[10:13] offset:16
    ds_write_b128 v8, v[10:13] offset:32
    ds_write_b128 v8, v[10:13] offset:80
    ds_write_b128 v8, v[10:13] offset:96
    ds_write_b128 v8, v[10:13] offset:128
    ds_write_b128 v8, v[10:13] offset:144
    ds_write_b128 v8, v[10:13] offset:160
    ds_write_b128 v8, v[10:13] offset:176
    ds_write_b128 v8, v[10:13] offset:192
    ds_write_b128 v8, v[10:13] offset:208
    ds_write_b128 v8, v[10:13] offset:224
    ds_write_b128 v8, v[10:13] offset:240
    ds_write_b128 v8, v[10:13] offset:256
    ds_write_b128 v8, v[10:13] offset:272
    ds_write_b128 v8, v[10:13] offset:288
    ds_write_b128 v8, v[10:13] offset:304
    ds_write_b128 v8, v[10:13] offset:320
    ds_write_b128 v8, v[10:13] offset:336
    ds_write_b128 v8, v[10:13] offset:352
L_noinit:
    s_waitcnt lgkmcnt(0)
    s_barrier
    v_and_b32 v2, 15, v0
    v_lshrrev_b32 v3, 4, v0
    s_mov_b32 s14, 0xffff0000
    s_getreg_b32 s92, hwreg(HW_REG_XCC_ID)
    s_and_b32 s92, s92, 15
    s_add_u32 s92, s92, 1
    s_lshl_b32 s92, s92, 24
    s_mov_b32 s16, 0x7060500
    s_mov_b32 s17, 0x7060501
    s_mov_b32 s18, 0x7060502
    s_mov_b32 s19, 0x7060503
    s_mov_b32 s20, 0x0c0c0400
    s_mov_b32 s21, 0x04000c0c
    s_mov_b32 s22, 0xffffff00
    v_mov_b32 v76, 133216
    s_cmp_eq_u32 s3, 12
    s_cbranch_scc1 L_a4
    s_cmp_gt_u32 s3, 12
    s_cbranch_scc1 L_pvw
    s_sub_u32 s9, s3, 8
    s_lshl_b32 s10, s4, 2
    s_lshr_b32 s11, s5, 3
    s_add_u32 s10, s10, s11
    s_lshl_b32 s10, s10, 7
    s_and_b32 s12, s5, 7
    s_lshl_b32 s12, s12, 4
    s_add_u32 s10, s10, s12
    s_lshl_b32 s12, s9, 2
    s_add_u32 s10, s10, s12
    v_add_u32 v6, s10, v3
    v_lshlrev_b32 v6, 4, v6
    v_add_u32 v6, 65536, v6
    s_lshl_b32 s10, s4, 2
    s_add_u32 s10, s10, s95
    s_lshl_b32 s10, s10, 3
    s_add_u32 s10, s10, s94
    s_lshl_b32 s10, s10, 4
    s_add_u32 s10, s10, s12
    v_add_u32 v7, s10, v3
    v_lshlrev_b32 v7, 4, v7
    v_add_u32 v7, 131072, v7
    v_cmp_eq_u32 s[58:59], 0, v2
    v_cmp_gt_u32 s[56:57], 2, v2
    s_add_u32 s12, s96, 1
    v_cndmask_b32 v6, v7, v6, s[58:59]
    v_cmp_gt_u32 s[60:61], s12, v2
    v_add_u32 v125, 131072, v6
    v_lshrrev_b32 v4, 2, v2
    v_lshl_add_u32 v5, v3, 2, v4
    v_lshl_add_u32 v4, v3, 3, v4
    v_and_b32 v7, 3, v2
    v_lshlrev_b32 v7, 3, v7
    s_lshl_b32 s12, s9, 5
    s_add_u32 s12, s12, 133632
    v_add_u32 v7, s12, v7
    v_lshl_add_u32 v4, v4, 7, v7
    v_lshl_add_u32 v5, v5, 7, v7
    s_mul_i32 s12, s11, 224
    s_add_u32 s12, s12, 156160
    v_lshlrev_b32 v7, 4, v3
    v_add_u32 v7, s12, v7
    v_lshlrev_b32 v8, 3, v3
    v_add_u32 v8, s12, v8
    s_lshl_b32 s12, s94, 7
    s_add_u32 s12, s12, 156160
    v_lshlrev_b32 v9, 4, v3
    v_add_u32 v9, s12, v9
    v_and_b32 v15, 31, v0
    v_lshrrev_b32 v10, 5, v0
    v_lshlrev_b32 v10, 11, v10
    v_lshl_add_u32 v10, v15, 4, v10
    s_lshl_b32 s12, s4, 13
    s_lshl_b32 s13, s9, 9
    s_add_u32 s12, s12, s13
    s_add_u32 s12, s12, 65536
    v_add_u32 v10, s12, v10
    v_add_u32 v11, 4096, v10
    s_lshl_b32 s12, s9, 8
    s_add_u32 s12, s12, 131072
    v_lshlrev_b32 v14, 3, v15
    v_add_u32 v14, s12, v14
    s_lshl_b32 s10, s4, 4
    s_lshl_b32 s12, s100, 2
    s_add_u32 s10, s10, s12
    s_add_u32 s10, s10, s9
    s_lshl_b32 s10, s10, 12
    s_add_u32 s10, s10, 1048576
    v_lshlrev_b32 v116, 4, v0
    v_add_u32 v116, s10, v116
    s_lshl_b32 s10, s4, 9
    s_add_u32 s10, s10, 327680
    v_lshlrev_b32 v117, 4, v15
    v_add_u32 v117, s10, v117
    s_lshl_b32 s12, s5, 4
    s_add_u32 s10, s10, s12
    v_mov_b32 v124, s10
    v_mov_b32 v118, v4
    s_lshl_b32 s10, s101, 2
    s_add_u32 s10, s10, s9
    s_lshl_b32 s10, s10, 5
    s_lshl_b32 s12, s4, 2
    s_add_u32 s10, s10, s12
    s_add_u32 s10, s10, s100
    s_lshl_b32 s10, s10, 7
    s_add_u32 s10, s10, 393216
    v_lshlrev_b32 v119, 4, v3
    v_add_u32 v119, s10, v119
    v_and_b32 v126, 7, v0
    v_lshl_add_u32 v126, v3, 3, v126
    v_lshlrev_b32 v126, 1, v126
    s_lshl_b32 s12, s9, 6
    s_add_u32 s12, s12, 158208
    v_add_u32 v126, s12, v126
    v_lshlrev_b32 v123, 4, v3
    v_add_u32 v123, 158208, v123
    v_lshrrev_b32 v127, 3, v0
    v_lshlrev_b32 v127, 2, v127
    s_mov_b32 s15, 0
L_prewa:
    ds_read_b128 v[96:99], v76
    ds_read_b128 v[100:103], v76 offset:16
    s_add_u32 s15, s15, 1
    s_cmp_gt_u32 s15, 16000000
    s_cbranch_scc1 L_prewa_ok
    s_waitcnt lgkmcnt(0)
    v_and_b32 v96, v96, v97
    v_and_b32 v98, v98, v99
    v_and_b32 v100, v100, v101
    v_and_b32 v102, v102, v103
    v_and_b32 v96, v96, v98
    v_and_b32 v100, v100, v102
    v_and_b32 v96, v96, v100
    s_nop 0
    v_readfirstlane_b32 s12, v96
    s_bitcmp1_b32 s12, 0
    s_cbranch_scc0 L_prewa
L_prewa_ok:
    s_waitcnt lgkmcnt(0)
    ds_read_b32 v78, v76 offset:32
    ds_read_b64_tr_b16 v[16:17], v4 offset:0
    ds_read_b64_tr_b16 v[18:19], v4 offset:512
    ds_read_b128 v[40:43], v7 offset:0
    ds_read_b64_tr_b16 v[20:21], v4 offset:4096
    ds_read_b64_tr_b16 v[22:23], v4 offset:4608
    ds_read_b128 v[44:47], v7 offset:64
    ds_read_b64_tr_b16 v[24:25], v4 offset:8192
    ds_read_b64_tr_b16 v[26:27], v4 offset:8704
    ds_read_b128 v[48:51], v7 offset:128
    ds_read_b64_tr_b16 v[28:29], v5 offset:12288
    ds_read_b64 v[52:53], v8 offset:192
    s_waitcnt lgkmcnt(8)
    v_mfma_f32_16x16x32_bf16 v[64:67], v[16:19], v[40:43], 0
    s_waitcnt lgkmcnt(5)
    v_mfma_f32_16x16x32_bf16 v[64:67], v[20:23], v[44:47], v[64:67]
    s_waitcnt lgkmcnt(2)
    v_mfma_f32_16x16x32_bf16 v[64:67], v[24:27], v[48:51], v[64:67]
    ds_read_b64_tr_b16 v[32:33], v4 offset:14336
    ds_read_b64_tr_b16 v[34:35], v4 offset:14848
    ds_read_b128 v[56:59], v9 offset:0
    ds_read_b64_tr_b16 v[36:37], v4 offset:18432
    ds_read_b64_tr_b16 v[38:39], v4 offset:18944
    ds_read_b128 v[60:63], v9 offset:64
    s_waitcnt lgkmcnt(6)
    v_mfma_f32_16x16x16_bf16 v[64:67], v[28:29], v[52:53], v[64:67]
    s_waitcnt lgkmcnt(3)
    v_mfma_f32_16x16x32_bf16 v[68:71], v[32:35], v[56:59], 0
    s_waitcnt lgkmcnt(0)
    v_mfma_f32_16x16x32_bf16 v[68:71], v[36:39], v[60:63], v[68:71]
    v_readfirstlane_b32 s44, v78
    s_lshl_b32 s12, s9, 2
    s_add_u32 s12, s12, 133264
    v_mov_b32 v16, s12
    v_mov_b32 v17, 1
    s_add_u32 s44, s44, 1
    s_xor_b32 s92, s92, s44
    v_mov_b32 v115, s44
    v_mov_b32 v114, s92
    v_cndmask_b32 v64, v68, v64, s[58:59]
    v_cndmask_b32 v65, v69, v65, s[58:59]
    v_cndmask_b32 v66, v70, v66, s[58:59]
    v_cndmask_b32 v67, v71, v67, s[58:59]
    v_perm_b32 v72, v64, v114, s16
    v_perm_b32 v73, v65, v114, s17
    v_perm_b32 v74, v66, v114, s18
    v_perm_b32 v75, v67, v114, s19
    v_perm_b32 v68, v64, v115, s16
    v_perm_b32 v69, v65, v115, s17
    v_perm_b32 v70, v66, v115, s18
    v_perm_b32 v71, v67, v115, s19
    s_mov_b64 exec, s[60:61]
    global_store_dwordx4 v6, v[72:75], s[42:43]
    global_store_dwordx4 v125, v[68:71], s[42:43] sc1
    s_mov_b64 exec, -1
    ds_write_b32 v16, v17
    s_lshl_b32 s12, s9, 14
    v_add_u32 v4, 0, v3
    v_xor_b32 v4, v4, v2
    v_lshlrev_b32 v4, 4, v4
    v_lshl_add_u32 v4, v2, 9, v4
    v_add_u32 v4, s12, v4
    v_add_u32 v5, 4, v3
    v_xor_b32 v5, v5, v2
    v_lshlrev_b32 v5, 4, v5
    v_lshl_add_u32 v5, v2, 9, v5
    v_add_u32 v5, s12, v5
    v_add_u32 v6, 8, v3
    v_xor_b32 v6, v6, v2
    v_lshlrev_b32 v6, 4, v6
    v_lshl_add_u32 v6, v2, 9, v6
    v_add_u32 v6, s12, v6
    v_add_u32 v7, 12, v3
    v_xor_b32 v7, v7, v2
    v_lshlrev_b32 v7, 4, v7
    v_lshl_add_u32 v7, v2, 9, v7
    v_add_u32 v7, s12, v7
    v_and_b32 v9, 1, v2
    v_lshlrev_b32 v8, 9, v9
    v_lshl_add_u32 v8, v3, 4, v8
    v_add_u32 v8, 131072, v8
    s_lshl_b32 s12, s9, 7
    s_add_u32 s12, s12, 132096
    v_lshlrev_b32 v120, 6, v9
    v_lshl_add_u32 v120, v3, 4, v120
    v_add_u32 v120, s12, v120
    s_lshl_b32 s12, s9, 3
    s_add_u32 s12, s12, 132608
    v_lshlrev_b32 v121, 5, v9
    v_add_u32 v121, s12, v121
    s_lshl_b32 s12, s9, 3
    s_add_u32 s12, s12, 133152
    v_mov_b32 v122, s12
    v_mov_b32 v9, 133120
    s_mov_b32 s88, 0x3db8aa3b
    s_mov_b32 s87, 0
    s_mov_b32 s15, 0
L_kmw:
    ds_read_b128 v[96:99], v9 offset:320
    ds_read_b128 v[100:103], v9 offset:336
    s_add_u32 s15, s15, 1
    s_cmp_gt_u32 s15, 16000000
    s_cbranch_scc1 L_kmw_ok
    s_waitcnt lgkmcnt(0)
    v_and_b32 v96, v96, v97
    v_and_b32 v98, v98, v99
    v_and_b32 v100, v100, v101
    v_and_b32 v102, v102, v103
    v_and_b32 v96, v96, v98
    v_and_b32 v100, v100, v102
    v_and_b32 v96, v96, v100
    s_nop 0
    v_readfirstlane_b32 s12, v96
    s_bitcmp1_b32 s12, 0
    s_cbranch_scc0 L_kmw
L_kmw_ok:
    s_waitcnt lgkmcnt(0)
    s_mov_b32 s13, 3
    s_mov_b32 s15, 0
L_pollql:
    global_load_dwordx4 v[96:99], v10, s[42:43] sc1
    global_load_dwordx4 v[100:103], v11, s[42:43] sc1
    s_add_u32 s15, s15, 1
    s_cmp_gt_u32 s15, 48
    s_cbranch_scc1 L_q_fallback
L_pollql_chk:
    s_cmp_lg_u32 s87, 0
    s_cbranch_scc1 L_kt0
    ds_read_b64 v[112:113], v122
    s_waitcnt lgkmcnt(0)
    v_and_b32 v112, v112, v113
    s_nop 0
    v_readfirstlane_b32 s87, v112
    s_cmp_eq_u32 s87, 0
    s_cbranch_scc1 L_kt0
    ds_read_b128 v[16:19], v4 offset:0
    ds_read_b128 v[48:51], v4 offset:8192
    ds_read_b128 v[20:23], v5 offset:0
    ds_read_b128 v[52:55], v5 offset:8192
    ds_read_b128 v[24:27], v6 offset:0
    ds_read_b128 v[56:59], v6 offset:8192
    ds_read_b128 v[28:31], v7 offset:0
    ds_read_b128 v[60:63], v7 offset:8192
    ds_read_b128 v[32:35], v4 offset:256
    ds_read_b128 v[64:67], v4 offset:8448
    ds_read_b128 v[36:39], v5 offset:256
    ds_read_b128 v[68:71], v5 offset:8448
    ds_read_b128 v[40:43], v6 offset:256
    ds_read_b128 v[72:75], v6 offset:8448
    ds_read_b128 v[44:47], v7 offset:256
    ds_read_b128 v[76:79], v7 offset:8448
L_kt0:
    s_waitcnt vmcnt(0)
    v_perm_b32 v104, v97, v96, s20
    v_perm_b32 v105, v99, v98, s21
    v_or_b32 v104, v104, v105
    v_cmp_eq_u32 s[46:47], s92, v104
    v_perm_b32 v104, v101, v100, s20
    v_perm_b32 v105, v103, v102, s21
    v_or_b32 v104, v104, v105
    v_cmp_eq_u32 vcc, s92, v104
    s_and_b64 s[46:47], s[46:47], vcc
    s_cmp_eq_u64 s[46:47], exec
    s_cbranch_scc0 L_pollql
L_pollql_done:
    s_waitcnt vmcnt(0)
    s_branch L_q_have
L_q_fallback:
    s_mov_b32 s13, 1
    s_waitcnt vmcnt(0)
    v_add_u32 v10, 131072, v10
    v_add_u32 v11, 131072, v11
    s_mov_b32 s15, 0
L_pollqg:
    global_load_dwordx4 v[96:99], v10, s[42:43] sc1
    global_load_dwordx4 v[100:103], v11, s[42:43] sc1
    s_add_u32 s15, s15, 1
    s_cmp_gt_u32 s15, 2000000
    s_cbranch_scc1 L_pollqg_done
L_pollqg_chk:
    s_waitcnt vmcnt(0)
    v_perm_b32 v104, v97, v96, s20
    v_perm_b32 v105, v99, v98, s21
    v_or_b32 v104, v104, v105
    v_cmp_eq_u32 s[46:47], s44, v104
    v_perm_b32 v104, v101, v100, s20
    v_perm_b32 v105, v103, v102, s21
    v_or_b32 v104, v104, v105
    v_cmp_eq_u32 vcc, s44, v104
    s_and_b64 s[46:47], s[46:47], vcc
    s_cmp_eq_u64 s[46:47], exec
    s_cbranch_scc0 L_pollqg
L_pollqg_done:
    s_waitcnt vmcnt(0)
L_q_have:
    v_and_b32 v96, s22, v96
    v_and_b32 v97, s22, v97
    v_and_b32 v98, s22, v98
    v_and_b32 v99, s22, v99
    v_and_b32 v100, s22, v100
    v_and_b32 v101, s22, v101
    v_and_b32 v102, s22, v102
    v_and_b32 v103, s22, v103
    v_add_f32 v96, v96, v100
    v_add_f32 v97, v97, v101
    v_add_f32 v98, v98, v102
    v_add_f32 v99, v99, v103
    v_mov_b32 v100, v96
    v_mov_b32 v101, v97
    v_mov_b32 v102, v98
    v_mov_b32 v103, v99
    s_nop 1
    v_permlane32_swap_b32 v96, v100
    v_permlane32_swap_b32 v97, v101
    v_permlane32_swap_b32 v98, v102
    v_permlane32_swap_b32 v99, v103
    s_nop 0
    v_add_f32 v96, v96, v100
    v_add_f32 v97, v97, v101
    v_add_f32 v98, v98, v102
    v_add_f32 v99, v99, v103
    v_cvt_pk_bf16_f32 v96, v96, v97
    v_cvt_pk_bf16_f32 v97, v98, v99
    ds_write_b64 v14, v[96:97]
    s_lshl_b32 s12, s9, 2
    s_add_u32 s12, s12, 133136
    v_mov_b32 v100, s12
    v_mov_b32 v101, s13
    s_waitcnt lgkmcnt(0)
    ds_write_b32 v100, v101
    s_cmp_lg_u32 s87, 0
    s_cbranch_scc1 L_khave
    s_mov_b32 s15, 0
L_kw:
    ds_read_b64 v[112:113], v122
    s_add_u32 s15, s15, 1
    s_cmp_gt_u32 s15, 16000000
    s_cbranch_scc1 L_kw_ok
    s_waitcnt lgkmcnt(0)
    v_and_b32 v112, v112, v113
    s_nop 0
    v_readfirstlane_b32 s12, v112
    s_bitcmp1_b32 s12, 0
    s_cbranch_scc0 L_kw
L_kw_ok:
    s_waitcnt lgkmcnt(0)
    ds_read_b128 v[16:19], v4 offset:0
    ds_read_b128 v[48:51], v4 offset:8192
    ds_read_b128 v[20:23], v5 offset:0
    ds_read_b128 v[52:55], v5 offset:8192
    ds_read_b128 v[24:27], v6 offset:0
    ds_read_b128 v[56:59], v6 offset:8192
    ds_read_b128 v[28:31], v7 offset:0
    ds_read_b128 v[60:63], v7 offset:8192
    ds_read_b128 v[32:35], v4 offset:256
    ds_read_b128 v[64:67], v4 offset:8448
    ds_read_b128 v[36:39], v5 offset:256
    ds_read_b128 v[68:71], v5 offset:8448
    ds_read_b128 v[40:43], v6 offset:256
    ds_read_b128 v[72:75], v6 offset:8448
    ds_read_b128 v[44:47], v7 offset:256
    ds_read_b128 v[76:79], v7 offset:8448
L_khave:
    s_mov_b32 s15, 0
L_qq:
    ds_read_b128 v[10:13], v9 offset:16
    s_add_u32 s15, s15, 1
    s_cmp_gt_u32 s15, 16000000
    s_cbranch_scc1 L_qq_ok
    s_waitcnt lgkmcnt(0)
    v_and_b32 v10, v10, v11
    v_and_b32 v12, v12, v13
    v_and_b32 v10, v10, v12
    s_nop 0
    v_readfirstlane_b32 s13, v10
    s_bitcmp1_b32 s13, 0
    s_cbranch_scc0 L_qq
L_qq_ok:
    s_waitcnt lgkmcnt(0)
    s_lshr_b32 s13, s13, 1
    ds_read_b128 v[80:83], v8 offset:0
    ds_read_b128 v[84:87], v8 offset:64
    ds_read_b128 v[88:91], v8 offset:128
    ds_read_b128 v[92:95], v8 offset:192
    ds_read_b128 v[96:99], v8 offset:256
    ds_read_b128 v[100:103], v8 offset:320
    ds_read_b128 v[104:107], v8 offset:384
    ds_read_b128 v[108:111], v8 offset:448
    s_waitcnt lgkmcnt(7)
    v_mfma_f32_16x16x32_bf16 v[4:7], v[16:19], v[80:83], 0
    v_mfma_f32_16x16x32_bf16 v[10:13], v[48:51], v[80:83], 0
    s_waitcnt lgkmcnt(6)
    v_mfma_f32_16x16x32_bf16 v[4:7], v[20:23], v[84:87], v[4:7]
    v_mfma_f32_16x16x32_bf16 v[10:13], v[52:55], v[84:87], v[10:13]
    s_waitcnt lgkmcnt(5)
    v_mfma_f32_16x16x32_bf16 v[4:7], v[24:27], v[88:91], v[4:7]
    v_mfma_f32_16x16x32_bf16 v[10:13], v[56:59], v[88:91], v[10:13]
    s_waitcnt lgkmcnt(4)
    v_mfma_f32_16x16x32_bf16 v[4:7], v[28:31], v[92:95], v[4:7]
    v_mfma_f32_16x16x32_bf16 v[10:13], v[60:63], v[92:95], v[10:13]
    s_waitcnt lgkmcnt(3)
    v_mfma_f32_16x16x32_bf16 v[4:7], v[32:35], v[96:99], v[4:7]
    v_mfma_f32_16x16x32_bf16 v[10:13], v[64:67], v[96:99], v[10:13]
    s_waitcnt lgkmcnt(2)
    v_mfma_f32_16x16x32_bf16 v[4:7], v[36:39], v[100:103], v[4:7]
    v_mfma_f32_16x16x32_bf16 v[10:13], v[68:71], v[100:103], v[10:13]
    s_waitcnt lgkmcnt(1)
    v_mfma_f32_16x16x32_bf16 v[4:7], v[40:43], v[104:107], v[4:7]
    v_mfma_f32_16x16x32_bf16 v[10:13], v[72:75], v[104:107], v[10:13]
    s_waitcnt lgkmcnt(0)
    v_mfma_f32_16x16x32_bf16 v[4:7], v[44:47], v[108:111], v[4:7]
    v_mfma_f32_16x16x32_bf16 v[10:13], v[76:79], v[108:111], v[10:13]
    s_nop 7
    v_max3_f32 v16, v4, v5, v6
    v_max3_f32 v17, v7, v10, v11
    v_max3_f32 v16, v16, v12, v13
    v_max_f32 v16, v16, v17
    v_mov_b32 v18, v16
    s_nop 1
    v_permlane16_swap_b32 v16, v18
    s_nop 0
    v_max_f32 v16, v16, v18
    v_mov_b32 v18, v16
    s_nop 1
    v_permlane32_swap_b32 v16, v18
    s_nop 0
    v_max_f32 v16, v16, v18
    v_mul_f32 v16, s88, v16
    v_fma_f32 v4, v4, s88, -v16
    v_fma_f32 v5, v5, s88, -v16
    v_fma_f32 v6, v6, s88, -v16
    v_fma_f32 v7, v7, s88, -v16
    v_fma_f32 v10, v10, s88, -v16
    v_fma_f32 v11, v11, s88, -v16
    v_fma_f32 v12, v12, s88, -v16
    v_fma_f32 v13, v13, s88, -v16
    v_exp_f32 v4, v4
    v_exp_f32 v5, v5
    v_exp_f32 v6, v6
    v_exp_f32 v7, v7
    v_exp_f32 v10, v10
    v_exp_f32 v11, v11
    v_exp_f32 v12, v12
    v_exp_f32 v13, v13
    v_cvt_pk_bf16_f32 v20, v4, v5
    v_cvt_pk_bf16_f32 v21, v6, v7
    v_cvt_pk_bf16_f32 v22, v10, v11
    v_cvt_pk_bf16_f32 v23, v12, v13
    s_mov_b64 exec, s[56:57]
    ds_write_b128 v120, v[20:23]
    s_mov_b64 exec, -1
    v_add_f32 v4, v4, v5
    v_add_f32 v6, v6, v7
    v_add_f32 v10, v10, v11
    v_add_f32 v12, v12, v13
    v_add_f32 v4, v4, v6
    v_add_f32 v10, v10, v12
    v_add_f32 v17, v4, v10
    v_mov_b32 v18, v17
    s_nop 1
    v_permlane16_swap_b32 v17, v18
    s_nop 0
    v_add_f32 v17, v17, v18
    v_mov_b32 v18, v17
    s_nop 1
    v_permlane32_swap_b32 v17, v18
    s_nop 0
    v_add_f32 v17, v17, v18
    s_mov_b64 exec, 3
    ds_write_b64 v121, v[16:17]
    s_mov_b64 exec, -1
    v_mov_b32 v101, 1
    s_lshl_b32 s12, s9, 2
    s_add_u32 s12, s12, 133344
    v_mov_b32 v100, s12
    s_waitcnt lgkmcnt(0)
    ds_write_b32 v100, v101
    s_cmp_eq_u32 s3, 8
    s_cbranch_scc0 L_nostat
    s_mov_b32 s15, 0
L_pwa:
    ds_read_b128 v[96:99], v9 offset:224
    s_add_u32 s15, s15, 1
    s_cmp_gt_u32 s15, 16000000
    s_cbranch_scc1 L_pwa_ok
    s_waitcnt lgkmcnt(0)
    v_and_b32 v96, v96, v97
    v_and_b32 v98, v98, v99
    v_and_b32 v96, v96, v98
    s_nop 0
    v_readfirstlane_b32 s12, v96
    s_bitcmp1_b32 s12, 0
    s_cbranch_scc0 L_pwa
L_pwa_ok:
    s_waitcnt lgkmcnt(0)
    v_mov_b32 v8, 132608
    ds_read_b128 v[80:83], v8 offset:0
    ds_read_b128 v[84:87], v8 offset:16
    ds_read_b128 v[88:91], v8 offset:32
    ds_read_b128 v[92:95], v8 offset:48
    s_waitcnt lgkmcnt(0)
    v_max3_f32 v96, v80, v82, v84
    v_max_f32 v96, v96, v86
    v_max3_f32 v98, v88, v90, v92
    v_max_f32 v98, v98, v94
    v_and_b32 v96, s22, v96
    v_and_b32 v98, s22, v98
    v_sub_f32 v80, v80, v96
    v_sub_f32 v82, v82, v96
    v_sub_f32 v84, v84, v96
    v_sub_f32 v86, v86, v96
    v_sub_f32 v88, v88, v98
    v_sub_f32 v90, v90, v98
    v_sub_f32 v92, v92, v98
    v_sub_f32 v94, v94, v98
    v_exp_f32 v80, v80
    v_exp_f32 v82, v82
    v_exp_f32 v84, v84
    v_exp_f32 v86, v86
    v_exp_f32 v88, v88
    v_exp_f32 v90, v90
    v_exp_f32 v92, v92
    v_exp_f32 v94, v94
    v_mul_f32 v97, v80, v81
    v_fmac_f32 v97, v82, v83
    v_fmac_f32 v97, v84, v85
    v_fmac_f32 v97, v86, v87
    v_mul_f32 v99, v88, v89
    v_fmac_f32 v99, v90, v91
    v_fmac_f32 v99, v92, v93
    v_fmac_f32 v99, v94, v95
    v_perm_b32 v96, v96, v115, s16
    v_perm_b32 v97, v97, v115, s17
    v_perm_b32 v98, v98, v115, s18
    v_perm_b32 v99, v99, v115, s19
    s_mov_b64 exec, 1
    s_cmp_lg_u32 s13, 0
    s_cbranch_scc1 L_stpub_loc
    global_store_dwordx4 v124, v[96:99], s[42:43] sc1
    s_branch L_stpub_end
L_stpub_loc:
    global_store_dwordx4 v124, v[96:99], s[42:43]
L_stpub_end:
    s_mov_b64 exec, -1
L_nostat:
    s_cmp_lg_u32 s99, 0
    s_cbranch_scc0 L_a_done
    s_mov_b32 s87, 0
    s_mov_b32 s15, 0
L_pollst:
    global_load_dwordx4 v[88:91], v117, s[42:43] sc1
    s_add_u32 s15, s15, 1
    s_cmp_gt_u32 s15, 2000000
    s_cbranch_scc1 L_pollst_done
L_pollst_chk:
    s_cmp_lg_u32 s87, 0
    s_cbranch_scc1 L_wta
    ds_read_b128 v[96:99], v9 offset:256
    ds_read_b128 v[100:103], v9 offset:272
    ds_read_b128 v[104:107], v9 offset:240
    s_waitcnt lgkmcnt(0)
    v_and_b32 v96, v96, v100
    v_and_b32 v97, v97, v101
    v_and_b32 v98, v98, v102
    v_and_b32 v99, v99, v103
    v_and_b32 v96, v96, v97
    v_and_b32 v98, v98, v99
    v_and_b32 v96, v96, v104
    v_and_b32 v96, v96, v98
    s_nop 0
    v_readfirstlane_b32 s87, v96
    s_cmp_eq_u32 s87, 0
    s_cbranch_scc1 L_wta
    ds_read_b64 v[12:13], v9
    ds_read_b64_tr_b16 v[32:33], v118 offset:16384
    ds_read_b64_tr_b16 v[34:35], v118 offset:16896
    ds_read_b128 v[40:43], v123 offset:256
    ds_read_b64_tr_b16 v[36:37], v118 offset:20480
    ds_read_b64_tr_b16 v[38:39], v118 offset:20992
    ds_read_b128 v[44:47], v123 offset:320
    ds_read_b64_tr_b16 v[16:17], v118 offset:0
    ds_read_b64_tr_b16 v[18:19], v118 offset:512
    ds_read_b64_tr_b16 v[20:21], v118 offset:4096
    ds_read_b64_tr_b16 v[22:23], v118 offset:4608
    ds_read_b64_tr_b16 v[24:25], v118 offset:8192
    ds_read_b64_tr_b16 v[26:27], v118 offset:8704
    ds_read_b64_tr_b16 v[28:29], v118 offset:12288
    ds_read_b64_tr_b16 v[30:31], v118 offset:12800
    s_waitcnt lgkmcnt(11)
    v_mfma_f32_16x16x32_bf16 v[48:51], v[32:35], v[40:43], 0
    s_waitcnt lgkmcnt(8)
    v_mfma_f32_16x16x32_bf16 v[48:51], v[36:39], v[44:47], v[48:51]
    s_nop 7
    v_mul_f32 v48, v48, v13
    v_mul_f32 v49, v49, v13
    v_mul_f32 v50, v50, v13
    v_mul_f32 v51, v51, v13
L_wta:
    s_waitcnt vmcnt(0)
    v_perm_b32 v92, v89, v88, s20
    v_perm_b32 v93, v91, v90, s21
    v_or_b32 v92, v92, v93
    v_cmp_eq_u32 s[46:47], s44, v92
    s_cmp_eq_u64 s[46:47], exec
    s_cbranch_scc0 L_pollst
L_pollst_done:
    s_waitcnt vmcnt(0)
    global_load_dwordx4 v[64:67], v116, s[42:43] offset:0 sc1
    global_load_dwordx4 v[68:71], v116, s[42:43] offset:1024 sc1
    global_load_dwordx4 v[72:75], v116, s[42:43] offset:2048 sc1
    global_load_dwordx4 v[76:79], v116, s[42:43] offset:3072 sc1
    v_and_b32 v88, s22, v88
    v_and_b32 v89, s22, v89
    v_and_b32 v90, s22, v90
    v_and_b32 v91, s22, v91
    v_mov_b32 v96, v88
    v_mov_b32 v97, v90
    s_nop 0
    v_max_f32_dpp v96, v96, v96 quad_perm:[1,0,3,2] row_mask:0xf bank_mask:0xf
    v_max_f32_dpp v97, v97, v97 quad_perm:[1,0,3,2] row_mask:0xf bank_mask:0xf
    s_nop 0
    v_max_f32_dpp v96, v96, v96 quad_perm:[2,3,0,1] row_mask:0xf bank_mask:0xf
    v_max_f32_dpp v97, v97, v97 quad_perm:[2,3,0,1] row_mask:0xf bank_mask:0xf
    s_nop 0
    v_max_f32_dpp v96, v96, v96 row_ror:4 row_mask:0xf bank_mask:0xf
    v_max_f32_dpp v97, v97, v97 row_ror:4 row_mask:0xf bank_mask:0xf
    s_nop 0
    v_max_f32_dpp v96, v96, v96 row_ror:8 row_mask:0xf bank_mask:0xf
    v_max_f32_dpp v97, v97, v97 row_ror:8 row_mask:0xf bank_mask:0xf
    v_mov_b32 v100, v96
    v_mov_b32 v101, v97
    s_nop 1
    v_permlane16_swap_b32 v96, v100
    v_permlane16_swap_b32 v97, v101
    s_nop 0
    v_max_f32 v96, v96, v100
    v_max_f32 v97, v97, v101
    v_sub_f32 v88, v88, v96
    v_sub_f32 v90, v90, v97
    v_exp_f32 v88, v88
    v_exp_f32 v90, v90
    s_nop 0
    v_mul_f32 v96, v88, v89
    v_mul_f32 v97, v90, v91
    s_nop 0
    v_add_f32_dpp v96, v96, v96 quad_perm:[1,0,3,2] row_mask:0xf bank_mask:0xf
    v_add_f32_dpp v97, v97, v97 quad_perm:[1,0,3,2] row_mask:0xf bank_mask:0xf
    s_nop 0
    v_add_f32_dpp v96, v96, v96 quad_perm:[2,3,0,1] row_mask:0xf bank_mask:0xf
    v_add_f32_dpp v97, v97, v97 quad_perm:[2,3,0,1] row_mask:0xf bank_mask:0xf
    s_nop 0
    v_add_f32_dpp v96, v96, v96 row_ror:4 row_mask:0xf bank_mask:0xf
    v_add_f32_dpp v97, v97, v97 row_ror:4 row_mask:0xf bank_mask:0xf
    s_nop 0
    v_add_f32_dpp v96, v96, v96 row_ror:8 row_mask:0xf bank_mask:0xf
    v_add_f32_dpp v97, v97, v97 row_ror:8 row_mask:0xf bank_mask:0xf
    v_mov_b32 v100, v96
    v_mov_b32 v101, v97
    s_nop 1
    v_permlane16_swap_b32 v96, v100
    v_permlane16_swap_b32 v97, v101
    s_nop 0
    v_add_f32 v96, v96, v100
    v_add_f32 v97, v97, v101
    v_rcp_f32 v96, v96
    v_rcp_f32 v97, v97
    s_nop 0
    v_mul_f32 v88, v88, v96
    v_mul_f32 v90, v90, v97
    ds_bpermute_b32 v52, v127, v88 offset:0
    ds_bpermute_b32 v53, v127, v90 offset:0
    ds_bpermute_b32 v54, v127, v88 offset:32
    ds_bpermute_b32 v55, v127, v90 offset:32
    ds_bpermute_b32 v56, v127, v88 offset:64
    ds_bpermute_b32 v57, v127, v90 offset:64
    ds_bpermute_b32 v58, v127, v88 offset:96
    ds_bpermute_b32 v59, v127, v90 offset:96
    s_waitcnt lgkmcnt(0)
    s_mov_b32 s86, 0
    s_mov_b32 s15, 0
    s_branch L_p2_chk
L_p2:
    s_bitcmp1_b32 s86, 0
    s_cbranch_scc1 L_p2_l0
    global_load_dwordx4 v[64:67], v116, s[42:43] offset:0 sc1
L_p2_l0:
    s_bitcmp1_b32 s86, 1
    s_cbranch_scc1 L_p2_l1
    global_load_dwordx4 v[68:71], v116, s[42:43] offset:1024 sc1
L_p2_l1:
    s_bitcmp1_b32 s86, 2
    s_cbranch_scc1 L_p2_l2
    global_load_dwordx4 v[72:75], v116, s[42:43] offset:2048 sc1
L_p2_l2:
    s_bitcmp1_b32 s86, 3
    s_cbranch_scc1 L_p2_l3
    global_load_dwordx4 v[76:79], v116, s[42:43] offset:3072 sc1
L_p2_l3:
    s_add_u32 s15, s15, 1
    s_cmp_gt_u32 s15, 2000000
    s_cbranch_scc1 L_p2_done
    s_cmp_lg_u32 s87, 0
    s_cbranch_scc1 L_wtb
    ds_read_b128 v[96:99], v9 offset:256
    ds_read_b128 v[100:103], v9 offset:272
    ds_read_b128 v[104:107], v9 offset:240
    s_waitcnt lgkmcnt(0)
    v_and_b32 v96, v96, v100
    v_and_b32 v97, v97, v101
    v_and_b32 v98, v98, v102
    v_and_b32 v99, v99, v103
    v_and_b32 v96, v96, v97
    v_and_b32 v98, v98, v99
    v_and_b32 v96, v96, v104
    v_and_b32 v96, v96, v98
    s_nop 0
    v_readfirstlane_b32 s87, v96
    s_cmp_eq_u32 s87, 0
    s_cbranch_scc1 L_wtb
    ds_read_b64 v[12:13], v9
    ds_read_b64_tr_b16 v[32:33], v118 offset:16384
    ds_read_b64_tr_b16 v[34:35], v118 offset:16896
    ds_read_b128 v[40:43], v123 offset:256
    ds_read_b64_tr_b16 v[36:37], v118 offset:20480
    ds_read_b64_tr_b16 v[38:39], v118 offset:20992
    ds_read_b128 v[44:47], v123 offset:320
    ds_read_b64_tr_b16 v[16:17], v118 offset:0
    ds_read_b64_tr_b16 v[18:19], v118 offset:512
    ds_read_b64_tr_b16 v[20:21], v118 offset:4096
    ds_read_b64_tr_b16 v[22:23], v118 offset:4608
    ds_read_b64_tr_b16 v[24:25], v118 offset:8192
    ds_read_b64_tr_b16 v[26:27], v118 offset:8704
    ds_read_b64_tr_b16 v[28:29], v118 offset:12288
    ds_read_b64_tr_b16 v[30:31], v118 offset:12800
    s_waitcnt lgkmcnt(11)
    v_mfma_f32_16x16x32_bf16 v[48:51], v[32:35], v[40:43], 0
    s_waitcnt lgkmcnt(8)
    v_mfma_f32_16x16x32_bf16 v[48:51], v[36:39], v[44:47], v[48:51]
    s_nop 7
    v_mul_f32 v48, v48, v13
    v_mul_f32 v49, v49, v13
    v_mul_f32 v50, v50, v13
    v_mul_f32 v51, v51, v13
L_wtb:
L_p2_chk:
    s_waitcnt vmcnt(0)
    s_bitcmp1_b32 s86, 0
    s_cbranch_scc1 L_p2_c0
    v_perm_b32 v92, v65, v64, s20
    v_perm_b32 v93, v67, v66, s21
    v_or_b32 v92, v92, v93
    v_cmp_eq_u32 s[46:47], s44, v92
    s_cmp_eq_u64 s[46:47], exec
    s_cselect_b32 s12, 1, 0
    s_or_b32 s86, s86, s12
L_p2_c0:
    s_bitcmp1_b32 s86, 1
    s_cbranch_scc1 L_p2_c1
    v_perm_b32 v92, v69, v68, s20
    v_perm_b32 v93, v71, v70, s21
    v_or_b32 v92, v92, v93
    v_cmp_eq_u32 s[46:47], s44, v92
    s_cmp_eq_u64 s[46:47], exec
    s_cselect_b32 s12, 2, 0
    s_or_b32 s86, s86, s12
L_p2_c1:
    s_bitcmp1_b32 s86, 2
    s_cbranch_scc1 L_p2_c2
    v_perm_b32 v92, v73, v72, s20
    v_perm_b32 v93, v75, v74, s21
    v_or_b32 v92, v92, v93
    v_cmp_eq_u32 s[46:47], s44, v92
    s_cmp_eq_u64 s[46:47], exec
    s_cselect_b32 s12, 4, 0
    s_or_b32 s86, s86, s12
L_p2_c2:
    s_bitcmp1_b32 s86, 3
    s_cbranch_scc1 L_p2_c3
    v_perm_b32 v92, v77, v76, s20
    v_perm_b32 v93, v79, v78, s21
    v_or_b32 v92, v92, v93
    v_cmp_eq_u32 s[46:47], s44, v92
    s_cmp_eq_u64 s[46:47], exec
    s_cselect_b32 s12, 8, 0
    s_or_b32 s86, s86, s12
L_p2_c3:
    s_cmp_eq_u32 s86, 15
    s_cbranch_scc0 L_p2
L_p2_done:
    s_waitcnt vmcnt(0)
    v_and_b32 v64, s22, v64
    v_and_b32 v65, s22, v65
    v_and_b32 v66, s22, v66
    v_and_b32 v67, s22, v67
    v_and_b32 v68, s22, v68
    v_and_b32 v69, s22, v69
    v_and_b32 v70, s22, v70
    v_and_b32 v71, s22, v71
    v_and_b32 v72, s22, v72
    v_and_b32 v73, s22, v73
    v_and_b32 v74, s22, v74
    v_and_b32 v75, s22, v75
    v_and_b32 v76, s22, v76
    v_and_b32 v77, s22, v77
    v_and_b32 v78, s22, v78
    v_and_b32 v79, s22, v79
    v_mul_f32 v96, v52, v64
    v_mul_f32 v97, v52, v65
    v_mul_f32 v98, v53, v66
    v_mul_f32 v99, v53, v67
    v_fmac_f32 v96, v54, v68
    v_fmac_f32 v97, v54, v69
    v_fmac_f32 v98, v55, v70
    v_fmac_f32 v99, v55, v71
    v_fmac_f32 v96, v56, v72
    v_fmac_f32 v97, v56, v73
    v_fmac_f32 v98, v57, v74
    v_fmac_f32 v99, v57, v75
    v_fmac_f32 v96, v58, v76
    v_fmac_f32 v97, v58, v77
    v_fmac_f32 v98, v59, v78
    v_fmac_f32 v99, v59, v79
    s_nop 0
    v_add_f32_dpp v96, v96, v96 row_ror:8 row_mask:0xf bank_mask:0xf
    v_add_f32_dpp v97, v97, v97 row_ror:8 row_mask:0xf bank_mask:0xf
    v_add_f32_dpp v98, v98, v98 row_ror:8 row_mask:0xf bank_mask:0xf
    v_add_f32_dpp v99, v99, v99 row_ror:8 row_mask:0xf bank_mask:0xf
    s_nop 0
    v_permlane16_swap_b32 v96, v97
    v_permlane16_swap_b32 v98, v99
    s_nop 0
    v_add_f32 v96, v96, v97
    v_add_f32 v98, v98, v99
    s_nop 1
    v_permlane32_swap_b32 v96, v98
    s_nop 0
    v_add_f32 v96, v96, v98
    v_cvt_pk_bf16_f32 v96, v96, v96
    ds_write_b16 v126, v96
    s_cmp_lg_u32 s87, 0
    s_cbranch_scc1 L_whave
    s_mov_b32 s15, 0
L_ww:
    ds_read_b128 v[96:99], v9 offset:256
    ds_read_b128 v[100:103], v9 offset:272
    ds_read_b128 v[104:107], v9 offset:240
    ds_read_b128 v[108:111], v9 offset:240
    s_add_u32 s15, s15, 1
    s_cmp_gt_u32 s15, 16000000
    s_cbranch_scc1 L_ww_ok
    s_waitcnt lgkmcnt(0)
    v_and_b32 v96, v96, v97
    v_and_b32 v98, v98, v99
    v_and_b32 v100, v100, v101
    v_and_b32 v102, v102, v103
    v_and_b32 v104, v104, v105
    v_and_b32 v106, v106, v107
    v_and_b32 v108, v108, v109
    v_and_b32 v110, v110, v111
    v_and_b32 v96, v96, v98
    v_and_b32 v100, v100, v102
    v_and_b32 v104, v104, v106
    v_and_b32 v108, v108, v110
    v_and_b32 v96, v96, v100
    v_and_b32 v104, v104, v108
    v_and_b32 v96, v96, v104
    s_nop 0
    v_readfirstlane_b32 s12, v96
    s_bitcmp1_b32 s12, 0
    s_cbranch_scc0 L_ww
L_ww_ok:
    s_waitcnt lgkmcnt(0)
    ds_read_b64 v[12:13], v9
    ds_read_b64_tr_b16 v[32:33], v118 offset:16384
    ds_read_b64_tr_b16 v[34:35], v118 offset:16896
    ds_read_b128 v[40:43], v123 offset:256
    ds_read_b64_tr_b16 v[36:37], v118 offset:20480
    ds_read_b64_tr_b16 v[38:39], v118 offset:20992
    ds_read_b128 v[44:47], v123 offset:320
    ds_read_b64_tr_b16 v[16:17], v118 offset:0
    ds_read_b64_tr_b16 v[18:19], v118 offset:512
    ds_read_b64_tr_b16 v[20:21], v118 offset:4096
    ds_read_b64_tr_b16 v[22:23], v118 offset:4608
    ds_read_b64_tr_b16 v[24:25], v118 offset:8192
    ds_read_b64_tr_b16 v[26:27], v118 offset:8704
    ds_read_b64_tr_b16 v[28:29], v118 offset:12288
    ds_read_b64_tr_b16 v[30:31], v118 offset:12800
    s_waitcnt lgkmcnt(11)
    v_mfma_f32_16x16x32_bf16 v[48:51], v[32:35], v[40:43], 0
    s_waitcnt lgkmcnt(8)
    v_mfma_f32_16x16x32_bf16 v[48:51], v[36:39], v[44:47], v[48:51]
    s_nop 7
    v_mul_f32 v48, v48, v13
    v_mul_f32 v49, v49, v13
    v_mul_f32 v50, v50, v13
    v_mul_f32 v51, v51, v13
L_whave:
    s_waitcnt lgkmcnt(0)
    s_barrier
    ds_read_b128 v[80:83], v123 offset:0
    ds_read_b128 v[84:87], v123 offset:64
    ds_read_b128 v[88:91], v123 offset:128
    ds_read_b128 v[92:95], v123 offset:192
    s_waitcnt lgkmcnt(3)
    v_mfma_f32_16x16x32_bf16 v[96:99], v[16:19], v[80:83], 0
    s_waitcnt lgkmcnt(2)
    v_mfma_f32_16x16x32_bf16 v[96:99], v[20:23], v[84:87], v[96:99]
    s_waitcnt lgkmcnt(1)
    v_mfma_f32_16x16x32_bf16 v[96:99], v[24:27], v[88:91], v[96:99]
    s_waitcnt lgkmcnt(0)
    v_mfma_f32_16x16x32_bf16 v[96:99], v[28:31], v[92:95], v[96:99]
    s_mov_b64 exec, s[58:59]
    s_nop 6
    v_fmac_f32 v48, v96, v12
    v_fmac_f32 v49, v97, v12
    v_fmac_f32 v50, v98, v12
    v_fmac_f32 v51, v99, v12
    v_perm_b32 v48, v48, v115, s16
    v_perm_b32 v49, v49, v115, s17
    v_perm_b32 v50, v50, v115, s18
    v_perm_b32 v51, v51, v115, s19
    global_store_dwordx4 v119, v[48:51], s[42:43] sc1
L_a_done:
    s_endpgm
L_a4:
    v_min_u32 v6, 55, v0
    v_lshlrev_b32 v6, 4, v6
    v_add_u32 v7, 156160, v6
    s_lshl_b32 s6, s4, 2
    s_add_u32 s6, s6, s100
    s_mul_i32 s6, s6, s96
    s_lshl_b32 s7, s6, 11
    s_add_u32 s7, s7, 131072
    v_lshlrev_b32 v4, 4, v0
    v_add_u32 v4, s7, v4
    v_min_u32 v5, 47, v0
    v_lshlrev_b32 v5, 4, v5
    v_add_u32 v5, s7, v5
    v_add_u32 v5, 1024, v5
    v_lshlrev_b32 v3, 3, v2
    s_lshl_b32 s7, s6, 7
    v_add_u32 v20, s7, v3
    global_load_dwordx2 v[90:91], v20, s[30:31]
    v_add_u32 v3, 158464, v3
    s_mov_b32 s15, 0
L_prewb:
    ds_read_b128 v[96:99], v76
    ds_read_b128 v[100:103], v76 offset:16
    s_add_u32 s15, s15, 1
    s_cmp_gt_u32 s15, 16000000
    s_cbranch_scc1 L_prewb_ok
    s_waitcnt lgkmcnt(0)
    v_and_b32 v96, v96, v97
    v_and_b32 v98, v98, v99
    v_and_b32 v100, v100, v101
    v_and_b32 v102, v102, v103
    v_and_b32 v96, v96, v98
    v_and_b32 v100, v100, v102
    v_and_b32 v96, v96, v100
    s_nop 0
    v_readfirstlane_b32 s12, v96
    s_bitcmp1_b32 s12, 0
    s_cbranch_scc0 L_prewb
L_prewb_ok:
    s_waitcnt lgkmcnt(0)
    ds_read_b32 v78, v76 offset:32
    ds_read_b128 v[96:99], v7
    ds_read_b128 v[100:103], v7 offset:1024
    v_mov_b32 v108, 0
    s_waitcnt lgkmcnt(0)
    v_readfirstlane_b32 s44, v78
    s_add_u32 s44, s44, 1
    s_xor_b32 s92, s92, s44
    v_lshlrev_b32 v2, 16, v96
    v_and_b32 v8, s14, v96
    v_lshlrev_b32 v9, 16, v100
    v_and_b32 v10, s14, v100
    v_mul_f32 v2, v2, v9
    v_mul_f32 v8, v8, v10
    v_cvt_pk_bf16_f32 v2, v2, v8
    v_lshlrev_b32 v8, 16, v2
    v_and_b32 v2, s14, v2
    v_add_f32 v108, v108, v8
    v_add_f32 v108, v108, v2
    v_lshlrev_b32 v2, 16, v97
    v_and_b32 v8, s14, v97
    v_lshlrev_b32 v9, 16, v101
    v_and_b32 v10, s14, v101
    v_mul_f32 v2, v2, v9
    v_mul_f32 v8, v8, v10
    v_cvt_pk_bf16_f32 v2, v2, v8
    v_lshlrev_b32 v8, 16, v2
    v_and_b32 v2, s14, v2
    v_add_f32 v108, v108, v8
    v_add_f32 v108, v108, v2
    v_lshlrev_b32 v2, 16, v98
    v_and_b32 v8, s14, v98
    v_lshlrev_b32 v9, 16, v102
    v_and_b32 v10, s14, v102
    v_mul_f32 v2, v2, v9
    v_mul_f32 v8, v8, v10
    v_cvt_pk_bf16_f32 v2, v2, v8
    v_lshlrev_b32 v8, 16, v2
    v_and_b32 v2, s14, v2
    v_add_f32 v108, v108, v8
    v_add_f32 v108, v108, v2
    v_lshlrev_b32 v2, 16, v99
    v_and_b32 v8, s14, v99
    v_lshlrev_b32 v9, 16, v103
    v_and_b32 v10, s14, v103
    v_mul_f32 v2, v2, v9
    v_mul_f32 v8, v8, v10
    v_cvt_pk_bf16_f32 v2, v2, v8
    v_lshlrev_b32 v8, 16, v2
    v_and_b32 v2, s14, v2
    v_add_f32 v108, v108, v8
    v_add_f32 v108, v108, v2
    v_cmp_gt_u32 vcc, 56, v0
    s_nop 1
    v_cndmask_b32 v108, 0, v108, vcc
    s_nop 1
    v_add_f32_dpp v108, v108, v108 quad_perm:[1,0,3,2] row_mask:0xf bank_mask:0xf
    s_nop 1
    v_add_f32_dpp v108, v108, v108 quad_perm:[2,3,0,1] row_mask:0xf bank_mask:0xf
    s_nop 1
    v_add_f32_dpp v108, v108, v108 row_ror:4 row_mask:0xf bank_mask:0xf
    s_nop 1
    v_add_f32_dpp v108, v108, v108 row_ror:8 row_mask:0xf bank_mask:0xf
    v_mov_b32 v109, v108
    s_nop 1
    v_permlane16_swap_b32 v108, v109
    s_nop 0
    v_add_f32 v108, v108, v109
    v_mov_b32 v109, v108
    s_nop 1
    v_permlane32_swap_b32 v108, v109
    s_nop 0
    v_add_f32 v108, v108, v109
    v_cvt_pk_bf16_f32 v108, v108, v108
    v_and_b32 v108, s14, v108
    v_mul_f32 v108, 0xbfb8aa3b, v108
    v_exp_f32 v108, v108
    s_nop 0
    v_add_f32 v108, 1.0, v108
    v_rcp_f32 v108, v108
    s_nop 0
    v_cvt_pk_bf16_f32 v108, v108, v108
    v_and_b32 v108, s14, v108
    v_sub_f32 v109, 1.0, v108
    v_cvt_pk_bf16_f32 v109, v109, v109
    v_and_b32 v109, s14, v109
    v_mov_b32 v20, 133120
    ds_write_b64 v20, v[108:109]
    v_mov_b32 v8, 1
    v_mov_b32 v9, 1
    v_mov_b32 v10, 1
    v_mov_b32 v11, 1
    ds_write_b128 v20, v[8:11] offset:288
    v_mov_b32 v24, 0
    v_mov_b32 v25, 0
    s_cmp_lg_u32 s96, 0
    s_cbranch_scc0 L_h_zero
    s_mov_b32 s15, 0
L_kmw4:
    ds_read_b128 v[96:99], v20 offset:320
    ds_read_b128 v[100:103], v20 offset:336
    s_add_u32 s15, s15, 1
    s_cmp_gt_u32 s15, 16000000
    s_cbranch_scc1 L_kmw4_ok
    s_waitcnt lgkmcnt(0)
    v_and_b32 v96, v96, v97
    v_and_b32 v98, v98, v99
    v_and_b32 v100, v100, v101
    v_and_b32 v102, v102, v103
    v_and_b32 v96, v96, v98
    v_and_b32 v100, v100, v102
    v_and_b32 v96, v96, v100
    s_nop 0
    v_readfirstlane_b32 s12, v96
    s_bitcmp1_b32 s12, 0
    s_cbranch_scc0 L_kmw4
L_kmw4_ok:
    s_waitcnt lgkmcnt(0)
    s_mov_b32 s15, 0
L_pollhl:
    global_load_dwordx4 v[8:11], v4, s[42:43] sc1
    global_load_dwordx4 v[16:19], v5, s[42:43] sc1
    s_add_u32 s15, s15, 1
    s_cmp_gt_u32 s15, 48
    s_cbranch_scc1 L_h_fallback
L_pollhl_chk:
    s_waitcnt vmcnt(0)
    v_perm_b32 v12, v9, v8, s20
    v_perm_b32 v13, v11, v10, s21
    v_or_b32 v12, v12, v13
    v_cmp_eq_u32 s[46:47], s92, v12
    v_perm_b32 v12, v17, v16, s20
    v_perm_b32 v13, v19, v18, s21
    v_or_b32 v12, v12, v13
    v_cmp_eq_u32 vcc, s92, v12
    s_and_b64 s[46:47], s[46:47], vcc
    s_cmp_eq_u64 s[46:47], exec
    s_cbranch_scc0 L_pollhl
L_pollhl_done:
    s_waitcnt vmcnt(0)
    s_branch L_h_have
L_h_fallback:
    s_waitcnt vmcnt(0)
    v_add_u32 v4, 131072, v4
    v_add_u32 v5, 131072, v5
    s_mov_b32 s15, 0
L_pollhg:
    global_load_dwordx4 v[8:11], v4, s[42:43] sc1
    global_load_dwordx4 v[16:19], v5, s[42:43] sc1
    s_add_u32 s15, s15, 1
    s_cmp_gt_u32 s15, 2000000
    s_cbranch_scc1 L_pollhg_done
L_pollhg_chk:
    s_waitcnt vmcnt(0)
    v_perm_b32 v12, v9, v8, s20
    v_perm_b32 v13, v11, v10, s21
    v_or_b32 v12, v12, v13
    v_cmp_eq_u32 s[46:47], s44, v12
    v_perm_b32 v12, v17, v16, s20
    v_perm_b32 v13, v19, v18, s21
    v_or_b32 v12, v12, v13
    v_cmp_eq_u32 vcc, s44, v12
    s_and_b64 s[46:47], s[46:47], vcc
    s_cmp_eq_u64 s[46:47], exec
    s_cbranch_scc0 L_pollhg
L_pollhg_done:
    s_waitcnt vmcnt(0)
L_h_have:
    v_and_b32 v8, s22, v8
    v_and_b32 v9, s22, v9
    v_and_b32 v10, s22, v10
    v_and_b32 v11, s22, v11
    v_and_b32 v16, s22, v16
    v_and_b32 v17, s22, v17
    v_and_b32 v18, s22, v18
    v_and_b32 v19, s22, v19
    v_cmp_gt_u32 vcc, 48, v0
    s_nop 1
    v_cndmask_b32 v16, 0, v16, vcc
    v_cndmask_b32 v17, 0, v17, vcc
    v_cndmask_b32 v18, 0, v18, vcc
    v_cndmask_b32 v19, 0, v19, vcc
    v_add_f32 v8, v8, v16
    v_add_f32 v9, v9, v17
    v_add_f32 v10, v10, v18
    v_add_f32 v11, v11, v19
    v_mov_b32 v16, v8
    v_mov_b32 v17, v9
    v_mov_b32 v18, v10
    v_mov_b32 v19, v11
    s_nop 1
    v_permlane16_swap_b32 v8, v16
    v_permlane16_swap_b32 v9, v17
    v_permlane16_swap_b32 v10, v18
    v_permlane16_swap_b32 v11, v19
    s_nop 0
    v_add_f32 v8, v8, v16
    v_add_f32 v9, v9, v17
    v_add_f32 v10, v10, v18
    v_add_f32 v11, v11, v19
    v_mov_b32 v16, v8
    v_mov_b32 v17, v9
    v_mov_b32 v18, v10
    v_mov_b32 v19, v11
    s_nop 1
    v_permlane32_swap_b32 v8, v16
    v_permlane32_swap_b32 v9, v17
    v_permlane32_swap_b32 v10, v18
    v_permlane32_swap_b32 v11, v19
    s_nop 0
    v_add_f32 v8, v8, v16
    v_add_f32 v9, v9, v17
    v_add_f32 v10, v10, v18
    v_add_f32 v11, v11, v19
    v_cvt_pk_bf16_f32 v2, v8, v9
    v_lshlrev_b32 v8, 16, v2
    v_and_b32 v9, s14, v2
    v_lshlrev_b32 v16, 16, v90
    v_and_b32 v17, s14, v90
    v_add_f32 v8, v8, v16
    v_add_f32 v9, v9, v17
    v_cvt_pk_bf16_f32 v2, v8, v9
    v_lshlrev_b32 v8, 16, v2
    v_and_b32 v9, s14, v2
    v_max_f32 v8, 0, v8
    v_max_f32 v9, 0, v9
    v_mul_f32 v8, v8, v8
    v_mul_f32 v9, v9, v9
    v_cvt_pk_bf16_f32 v24, v8, v9
    v_cvt_pk_bf16_f32 v2, v10, v11
    v_lshlrev_b32 v10, 16, v2
    v_and_b32 v11, s14, v2
    v_lshlrev_b32 v16, 16, v91
    v_and_b32 v17, s14, v91
    v_add_f32 v10, v10, v16
    v_add_f32 v11, v11, v17
    v_cvt_pk_bf16_f32 v2, v10, v11
    v_lshlrev_b32 v10, 16, v2
    v_and_b32 v11, s14, v2
    v_max_f32 v10, 0, v10
    v_max_f32 v11, 0, v11
    v_mul_f32 v10, v10, v10
    v_mul_f32 v11, v11, v11
    v_cvt_pk_bf16_f32 v25, v10, v11
L_h_zero:
    s_mov_b64 exec, 0xffff
    ds_write_b64 v3, v[24:25]
    s_mov_b64 exec, -1
    v_mov_b32 v8, 1
    v_mov_b32 v9, 1
    v_mov_b32 v10, 1
    v_mov_b32 v11, 1
    v_mov_b32 v2, 133360
    s_waitcnt vmcnt(0) lgkmcnt(0)
    ds_write_b128 v2, v[8:11]
    s_waitcnt lgkmcnt(0)
L_pvw:
    s_sub_u32 s7, s3, 12
    s_lshl_b32 s7, s7, 1
    v_and_b32 v13, 15, v0
    v_lshrrev_b32 v14, 4, v0
    v_and_b32 v15, 1, v13
    v_lshlrev_b32 v96, 6, v15
    v_lshl_add_u32 v96, v14, 4, v96
    v_add_u32 v96, 132096, v96
    v_mov_b32 v97, 132608
    v_lshrrev_b32 v98, 2, v13
    v_lshl_add_u32 v99, v14, 2, v98
    v_and_b32 v100, 7, v99
    v_and_b32 v101, 3, v13
    s_add_u32 s13, s7, 0
    v_xor_b32 v102, s13, v100
    v_lshlrev_b32 v102, 5, v102
    v_lshl_add_u32 v102, v99, 9, v102
    v_lshl_add_u32 v102, v101, 3, v102
    v_add_u32 v102, 65536, v102
    s_add_u32 s13, s7, 1
    v_xor_b32 v103, s13, v100
    v_lshlrev_b32 v103, 5, v103
    v_lshl_add_u32 v103, v99, 9, v103
    v_lshl_add_u32 v103, v101, 3, v103
    v_add_u32 v103, 65536, v103
    s_lshl_b32 s13, s4, 4
    s_add_u32 s13, s13, s7
    v_lshrrev_b32 v104, 3, v13
    v_add_u32 v104, s13, v104
    v_lshlrev_b32 v104, 5, v104
    v_add_u32 v104, s5, v104
    v_lshlrev_b32 v104, 7, v104
    v_and_b32 v105, 7, v13
    v_lshl_add_u32 v104, v105, 4, v104
    v_add_u32 v104, 1048576, v104
    s_mov_b32 s60, 0xffff
    s_mov_b32 s61, 0
    v_mov_b32 v95, 133136
    v_mov_b32 v93, 133248
    s_mov_b32 s15, 0
L_vaw:
    ds_read_b128 v[84:87], v95 offset:144
    ds_read_b128 v[88:91], v95 offset:160
    s_add_u32 s15, s15, 1
    s_cmp_gt_u32 s15, 16000000
    s_cbranch_scc1 L_vaw_ok
    s_waitcnt lgkmcnt(0)
    v_and_b32 v84, v84, v85
    v_and_b32 v86, v86, v87
    v_and_b32 v88, v88, v89
    v_and_b32 v90, v90, v91
    v_and_b32 v84, v84, v86
    v_and_b32 v88, v88, v90
    v_and_b32 v84, v84, v88
    s_nop 0
    v_readfirstlane_b32 s12, v84
    s_bitcmp1_b32 s12, 0
    s_cbranch_scc0 L_vaw
L_vaw_ok:
    s_waitcnt lgkmcnt(0)
    ds_read_b64_tr_b16 v[44:45], v102 offset:0
    ds_read_b64_tr_b16 v[46:47], v102 offset:8192
    ds_read_b64_tr_b16 v[48:49], v103 offset:0
    ds_read_b64_tr_b16 v[50:51], v103 offset:8192
    ds_read_b64_tr_b16 v[52:53], v102 offset:16384
    ds_read_b64_tr_b16 v[54:55], v102 offset:24576
    ds_read_b64_tr_b16 v[56:57], v103 offset:16384
    ds_read_b64_tr_b16 v[58:59], v103 offset:24576
    ds_read_b64_tr_b16 v[60:61], v102 offset:32768
    ds_read_b64_tr_b16 v[62:63], v102 offset:40960
    ds_read_b64_tr_b16 v[64:65], v103 offset:32768
    ds_read_b64_tr_b16 v[66:67], v103 offset:40960
    v_add_u32 v100, 0x8000, v104
    s_mov_b32 s15, 0
L_pw:
    ds_read_b128 v[84:87], v95 offset:208
    s_add_u32 s15, s15, 1
    s_cmp_gt_u32 s15, 16000000
    s_cbranch_scc1 L_pw_ok
    s_waitcnt lgkmcnt(0)
    v_and_b32 v84, v84, v85
    v_and_b32 v86, v86, v87
    v_and_b32 v84, v84, v86
    s_nop 0
    v_readfirstlane_b32 s12, v84
    s_bitcmp1_b32 s12, 0
    s_cbranch_scc0 L_pw
L_pw_ok:
    s_waitcnt lgkmcnt(0)
    ds_read_b128 v[16:19], v96 offset:0
    ds_read_b128 v[20:23], v96 offset:128
    ds_read_b128 v[24:27], v96 offset:256
    ds_read_b128 v[28:31], v96 offset:384
    ds_read_b128 v[112:115], v97 offset:0
    ds_read_b128 v[116:119], v97 offset:16
    ds_read_b128 v[120:123], v97 offset:32
    ds_read_b128 v[124:127], v97 offset:48
    ds_read_b128 v[84:87], v95
    ds_read_b32 v105, v93
    s_waitcnt lgkmcnt(9)
    v_mfma_f32_16x16x32_bf16 v[76:79], v[16:19], v[44:47], 0
    v_mfma_f32_16x16x32_bf16 v[80:83], v[16:19], v[48:51], 0
    s_waitcnt lgkmcnt(8)
    v_mfma_f32_16x16x32_bf16 v[88:91], v[20:23], v[52:55], 0
    v_mfma_f32_16x16x32_bf16 v[32:35], v[20:23], v[56:59], 0
    s_waitcnt lgkmcnt(7)
    v_mfma_f32_16x16x32_bf16 v[36:39], v[24:27], v[60:63], 0
    v_mfma_f32_16x16x32_bf16 v[40:43], v[24:27], v[64:67], 0
    s_waitcnt lgkmcnt(0)
    ds_read_b64_tr_b16 v[44:45], v102 offset:256
    ds_read_b64_tr_b16 v[46:47], v102 offset:8448
    ds_read_b64_tr_b16 v[48:49], v103 offset:256
    ds_read_b64_tr_b16 v[50:51], v103 offset:8448
    ds_read_b64_tr_b16 v[52:53], v102 offset:16640
    ds_read_b64_tr_b16 v[54:55], v102 offset:24832
    ds_read_b64_tr_b16 v[56:57], v103 offset:16640
    ds_read_b64_tr_b16 v[58:59], v103 offset:24832
    ds_read_b64_tr_b16 v[60:61], v102 offset:33024
    ds_read_b64_tr_b16 v[62:63], v102 offset:41216
    ds_read_b64_tr_b16 v[64:65], v103 offset:33024
    ds_read_b64_tr_b16 v[66:67], v103 offset:41216
    v_add_u32 v105, 1, v105
    v_max3_f32 v98, v112, v114, v116
    v_max_f32 v98, v98, v118
    v_max3_f32 v99, v120, v122, v124
    v_max_f32 v99, v99, v126
    v_and_b32 v98, s22, v98
    v_and_b32 v99, s22, v99
    v_and_b32 v84, v84, v85
    v_and_b32 v86, v86, v87
    v_sub_f32 v112, v112, v98
    v_sub_f32 v114, v114, v98
    v_sub_f32 v116, v116, v98
    v_sub_f32 v118, v118, v98
    v_sub_f32 v120, v120, v99
    v_sub_f32 v122, v122, v99
    v_sub_f32 v124, v124, v99
    v_sub_f32 v126, v126, v99
    v_and_b32 v84, v84, v86
    v_exp_f32 v112, v112
    v_exp_f32 v114, v114
    v_exp_f32 v116, v116
    v_exp_f32 v118, v118
    v_exp_f32 v120, v120
    v_exp_f32 v122, v122
    v_exp_f32 v124, v124
    v_exp_f32 v126, v126
    v_readfirstlane_b32 s13, v84
    v_mov_b32 v108, 0
    v_mov_b32 v8, 0
    v_mov_b32 v109, 0
    v_mov_b32 v9, 0
    v_mov_b32 v110, 0
    v_mov_b32 v10, 0
    v_mov_b32 v111, 0
    v_mov_b32 v11, 0
    s_lshr_b32 s13, s13, 1
    v_fmac_f32 v108, v112, v76
    v_fmac_f32 v110, v120, v77
    v_fmac_f32 v109, v112, v80
    v_fmac_f32 v111, v120, v81
    v_fmac_f32 v108, v114, v88
    v_fmac_f32 v110, v122, v89
    v_fmac_f32 v109, v114, v32
    v_fmac_f32 v111, v122, v33
    v_fmac_f32 v108, v116, v36
    v_fmac_f32 v110, v124, v37
    v_fmac_f32 v109, v116, v40
    v_fmac_f32 v111, v124, v41
    s_waitcnt lgkmcnt(8)
    v_mfma_f32_16x16x32_bf16 v[76:79], v[16:19], v[44:47], 0
    v_mfma_f32_16x16x32_bf16 v[80:83], v[16:19], v[48:51], 0
    s_waitcnt lgkmcnt(4)
    v_mfma_f32_16x16x32_bf16 v[88:91], v[20:23], v[52:55], 0
    v_mfma_f32_16x16x32_bf16 v[32:35], v[20:23], v[56:59], 0
    s_waitcnt lgkmcnt(0)
    v_mfma_f32_16x16x32_bf16 v[36:39], v[24:27], v[60:63], 0
    v_mfma_f32_16x16x32_bf16 v[40:43], v[24:27], v[64:67], 0
    s_nop 3
    v_fmac_f32 v8, v112, v76
    v_fmac_f32 v10, v120, v77
    v_fmac_f32 v9, v112, v80
    v_fmac_f32 v11, v120, v81
    v_fmac_f32 v8, v114, v88
    v_fmac_f32 v10, v122, v89
    v_fmac_f32 v9, v114, v32
    v_fmac_f32 v11, v122, v33
    v_fmac_f32 v8, v116, v36
    v_fmac_f32 v10, v124, v37
    v_fmac_f32 v9, v116, v40
    v_fmac_f32 v11, v124, v41
    s_mov_b32 s15, 0
L_vbw:
    ds_read_b128 v[84:87], v95 offset:176
    ds_read_b128 v[68:71], v95 offset:192
    s_add_u32 s15, s15, 1
    s_cmp_gt_u32 s15, 16000000
    s_cbranch_scc1 L_vbw_ok
    s_waitcnt lgkmcnt(0)
    v_and_b32 v84, v84, v85
    v_and_b32 v86, v86, v87
    v_and_b32 v68, v68, v69
    v_and_b32 v70, v70, v71
    v_and_b32 v84, v84, v86
    v_and_b32 v68, v68, v70
    v_and_b32 v84, v84, v68
    s_nop 0
    v_readfirstlane_b32 s12, v84
    s_bitcmp1_b32 s12, 0
    s_cbranch_scc0 L_vbw
L_vbw_ok:
    s_waitcnt lgkmcnt(0)
    ds_read_b64_tr_b16 v[68:69], v102 offset:49152
    ds_read_b64_tr_b16 v[70:71], v102 offset:57344
    ds_read_b64_tr_b16 v[72:73], v103 offset:49152
    ds_read_b64_tr_b16 v[74:75], v103 offset:57344
    ds_read_b64_tr_b16 v[44:45], v102 offset:49408
    ds_read_b64_tr_b16 v[46:47], v102 offset:57600
    ds_read_b64_tr_b16 v[48:49], v103 offset:49408
    ds_read_b64_tr_b16 v[50:51], v103 offset:57600
    s_waitcnt lgkmcnt(6)
    v_mfma_f32_16x16x32_bf16 v[76:79], v[28:31], v[68:71], 0
    s_waitcnt lgkmcnt(4)
    v_mfma_f32_16x16x32_bf16 v[80:83], v[28:31], v[72:75], 0
    s_waitcnt lgkmcnt(2)
    v_mfma_f32_16x16x32_bf16 v[88:91], v[28:31], v[44:47], 0
    s_waitcnt lgkmcnt(0)
    v_mfma_f32_16x16x32_bf16 v[32:35], v[28:31], v[48:51], 0
    s_mov_b64 exec, s[60:61]
    s_nop 0
    v_fmac_f32 v108, v118, v76
    v_fmac_f32 v110, v126, v77
    v_fmac_f32 v109, v118, v80
    v_fmac_f32 v111, v126, v81
    v_perm_b32 v108, v108, v105, s16
    v_perm_b32 v109, v109, v105, s17
    v_perm_b32 v110, v110, v105, s18
    v_perm_b32 v111, v111, v105, s19
    v_fmac_f32 v8, v118, v88
    v_fmac_f32 v10, v126, v89
    v_fmac_f32 v9, v118, v32
    v_fmac_f32 v11, v126, v33
    v_perm_b32 v8, v8, v105, s16
    v_perm_b32 v9, v9, v105, s17
    v_perm_b32 v10, v10, v105, s18
    v_perm_b32 v11, v11, v105, s19
    s_cmp_lg_u32 s13, 0
    s_cbranch_scc1 L_spub_loc
    global_store_dwordx4 v104, v[108:111], s[42:43] sc1
    global_store_dwordx4 v100, v[8:11], s[42:43] sc1
    s_branch L_spub_end
L_spub_loc:
    global_store_dwordx4 v104, v[108:111], s[42:43]
    global_store_dwordx4 v100, v[8:11], s[42:43]
L_spub_end:
    s_mov_b64 exec, -1
    s_cmp_eq_u32 s3, 12
    s_cbranch_scc0 L_end
    s_cmp_lt_u32 s2, 28
    s_cbranch_scc0 L_end
    s_min_u32 s7, s2, 27
    s_lshl_b32 s8, s7, 12
    s_add_u32 s8, s8, 393216
    v_lshrrev_b32 v104, 2, v0
    v_lshlrev_b32 v104, 7, v104
    v_and_b32 v14, 3, v0
    v_lshl_add_u32 v104, v14, 4, v104
    v_add_u32 v104, s8, v104
    s_lshl_b32 s7, s7, 5
    v_lshlrev_b32 v14, 3, v14
    v_lshrrev_b32 v20, 4, v0
    v_lshl_add_u32 v14, v20, 1, v14
    v_add_u32 v14, s7, v14
    global_load_ushort v92, v14, s[34:35]
    v_mov_b32 v20, 133120
    ds_read_b64 v[108:109], v20
    s_waitcnt vmcnt(0) lgkmcnt(0)
    v_lshlrev_b32 v16, 16, v92
    v_mul_f32 v16, v16, v109
    v_mov_b32 v2, 0
    v_mov_b32 v4, s44
    v_and_b32 v20, 12, v0
    v_cmp_eq_u32 s[62:63], 0, v20
    s_barrier
    s_mov_b32 s15, 0
L_poll4:
    global_load_dwordx4 v[64:67], v104, s[42:43] sc1
    global_load_dwordx4 v[68:71], v104, s[42:43] offset:2048 sc1
    s_add_u32 s15, s15, 1
    s_cmp_gt_u32 s15, 2000000
    s_cbranch_scc1 L_poll4_done
L_poll4_chk:
    s_waitcnt vmcnt(0)
    v_perm_b32 v92, v65, v64, s20
    v_perm_b32 v93, v67, v66, s21
    v_or_b32 v92, v92, v93
    v_cmp_eq_u32 s[46:47], s44, v92
    v_perm_b32 v92, v69, v68, s20
    v_perm_b32 v93, v71, v70, s21
    v_or_b32 v92, v92, v93
    v_cmp_eq_u32 vcc, s44, v92
    s_and_b64 s[46:47], s[46:47], vcc
    s_cmp_eq_u64 s[46:47], exec
    s_cbranch_scc0 L_poll4
L_poll4_done:
    s_waitcnt vmcnt(0)
    v_and_b32 v64, s22, v64
    v_and_b32 v65, s22, v65
    v_and_b32 v66, s22, v66
    v_and_b32 v67, s22, v67
    v_and_b32 v68, s22, v68
    v_and_b32 v69, s22, v69
    v_and_b32 v70, s22, v70
    v_and_b32 v71, s22, v71
    v_add_f32 v80, v64, v68
    v_add_f32 v81, v65, v69
    v_add_f32 v82, v66, v70
    v_add_f32 v83, v67, v71
    s_nop 0
    v_add_f32_dpp v80, v80, v80 row_ror:4 row_mask:0xf bank_mask:0xf
    v_add_f32_dpp v81, v81, v81 row_ror:4 row_mask:0xf bank_mask:0xf
    v_add_f32_dpp v82, v82, v82 row_ror:4 row_mask:0xf bank_mask:0xf
    v_add_f32_dpp v83, v83, v83 row_ror:4 row_mask:0xf bank_mask:0xf
    s_nop 0
    v_add_f32_dpp v80, v80, v80 row_ror:8 row_mask:0xf bank_mask:0xf
    v_add_f32_dpp v81, v81, v81 row_ror:8 row_mask:0xf bank_mask:0xf
    v_add_f32_dpp v82, v82, v82 row_ror:8 row_mask:0xf bank_mask:0xf
    v_add_f32_dpp v83, v83, v83 row_ror:8 row_mask:0xf bank_mask:0xf
    s_nop 0
    v_permlane16_swap_b32 v80, v81
    v_permlane16_swap_b32 v82, v83
    s_nop 0
    v_add_f32 v80, v80, v81
    v_add_f32 v82, v82, v83
    s_nop 1
    v_permlane32_swap_b32 v80, v82
    s_nop 0
    v_add_f32 v80, v80, v82
    v_add_f32 v80, v80, v16
    v_cvt_pk_bf16_f32 v80, v80, v80
    s_mov_b64 exec, s[62:63]
    global_store_short v14, v80, s[38:39]
    s_cmp_eq_u32 s2, 0
    s_cbranch_scc0 L_noepoch
    s_mov_b64 exec, 1
    global_store_dword v2, v4, s[42:43] sc1
L_noepoch:
L_end:
    s_endpgm
.section .rodata,"a"
.p2align 6
.amdhsa_kernel gated_mix__sliding_block_cached__dense_activation_squared_relu__decode_kernel
  .amdhsa_next_free_vgpr 128
  .amdhsa_next_free_sgpr 102
  .amdhsa_accum_offset 128
  .amdhsa_group_segment_fixed_size 0
  .amdhsa_kernarg_size 112
  .amdhsa_user_sgpr_count 2
  .amdhsa_user_sgpr_kernarg_segment_ptr 1
  .amdhsa_system_sgpr_workgroup_id_x 1
.end_amdhsa_kernel
```
